```python
import torch

def _softmax(x, axis=-1):
    return torch.softmax(x, dim=axis)
def _gelu(x):
    return torch.nn.functional.gelu(x, approximate="tanh")
def _silu(x):
    return torch.nn.functional.silu(x)
def _sigmoid(x):
    return torch.sigmoid(x)
def _layernorm(x, axis=-1, eps=1e-5):
    m = x.mean(dim=axis, keepdim=True)
    v = x.var(dim=axis, keepdim=True, unbiased=False)
    return (x - m) / torch.sqrt(v + eps)
def _scatter_add(tgt, idx, src, axis=0):
    return tgt.clone().index_add_(axis, idx, src)
def _segment_sum(src, seg, n):
    out = torch.zeros((n,) + src.shape[1:], dtype=src.dtype)
    return out.index_add_(0, seg, src)
def _pad(x, pw):
    flat = tuple(v for pair in reversed(pw) for v in pair)
    return torch.nn.functional.pad(x, flat)

kernel_name = 'recurrent_scan__sliding_block_cached__glu_gated_reglu__decode'

def setup_inputs():

    _w = (lambda a: (lambda t: t.to(torch.bfloat16) if t.is_floating_point() else t)(torch.as_tensor(a)))
    def _A_setup():
        B, Sq, D = 8, 1, 512
        Hq, Hkv, Sk, Dh = 32, 8, 4096, 128
        assert Hq % Hkv == 0, (Hq, Hkv)
        return {
            "x": _w((lambda *s: torch.randn(*s, dtype=torch.bfloat16) * 0.05)(B, Sq, D)),
            "k_cache": _w((lambda *s: torch.randn(*s, dtype=torch.bfloat16) * 1.6)(B, Hkv, Sk, Dh)),
            "v_cache": _w((lambda *s: torch.randn(*s, dtype=torch.bfloat16) * 1.6)(B, Hkv, Sk, Dh)),
            "wq": _w((lambda *s: torch.randn(*s, dtype=torch.bfloat16) * 1.6)(D, Hq * Dh) * (D ** -0.5)),
            "wo": _w((lambda *s: torch.randn(*s, dtype=torch.bfloat16) * 1.6)(Hq * Dh, D) * ((Hq * Dh) ** -0.5)),
        }
    _A_in = _A_setup()

    def _B_setup():
        B, S, D, F = 8, 1, 512, 1792
        return {
            "x": _w((lambda *s: torch.randn(*s, dtype=torch.bfloat16) * 0.05)(B, S, D)),
            "W_gate": _w((lambda *s: torch.randn(*s, dtype=torch.bfloat16) * 0.2)(D, F) * (2.0 / D) ** 0.5),
            "W_up": _w((lambda *s: torch.randn(*s, dtype=torch.bfloat16) * 0.2)(D, F) * (2.0 / D) ** 0.5),
            "W_down": _w((lambda *s: torch.randn(*s, dtype=torch.bfloat16) * 0.2)(F, D) * (1.0 / F) ** 0.5),
        }
    _B_in = _B_setup()

    return {
        "A_x": _A_in["x"],
        "A_k_cache": _A_in["k_cache"],
        "A_v_cache": _A_in["v_cache"],
        "A_wq": _A_in["wq"],
        "A_wo": _A_in["wo"],
        "B_x": _B_in["x"],
        "B_W_gate": _B_in["W_gate"],
        "B_W_up": _B_in["W_up"],
        "B_W_down": _B_in["W_down"],
    }

def reference(A_x, A_k_cache, A_v_cache, A_wq, A_wo, B_x, B_W_gate, B_W_up, B_W_down):
    def _A_ref(x, k_cache, v_cache, wq, wo):
        B, Sq, D = x.shape
        Hq, Dh = 32, 128
        Hkv, Sk = k_cache.shape[1], k_cache.shape[2]
        W = min(4096, max(256, Sk // 4))
        rep = Hq // Hkv
        q = (lambda x, *d: x.permute(*d))((x @ wq).reshape(B, Sq, Hq, Dh), 0, 2, 1, 3)
        k = (lambda x, n, axis: torch.repeat_interleave(x, n, dim=axis))(k_cache[:, :, Sk - W:, :], rep, axis=1)
        v = (lambda x, n, axis: torch.repeat_interleave(x, n, dim=axis))(v_cache[:, :, Sk - W:, :], rep, axis=1)
        scores = torch.einsum("bhqd,bhkd->bhqk", q, k) * (Dh ** -0.5)
        p = _softmax(scores, axis=-1)
        o = torch.einsum("bhqk,bhkd->bhqd", p, v)
        return (lambda x, *d: x.permute(*d))(o, 0, 2, 1, 3).reshape(B, Sq, Hq * Dh) @ wo

    def _B_ref(x, W_gate, W_up, W_down):
        gate = torch.einsum("bsd,df->bsf", x, W_gate)
        up = torch.einsum("bsd,df->bsf", x, W_up)
        gate = gate * (lambda x, dt: x.to(dt))(gate > 0, gate.dtype)
        h = gate * up
        return torch.einsum("bsf,fd->bsd", h, W_down)

    x = A_x
    xn = _layernorm(x, axis=-1)
    s = _A_ref(xn, A_k_cache, A_v_cache, A_wq, A_wo)
    g = _silu(_B_ref(xn, B_W_gate, B_W_up, B_W_down))
    return x + s * g
```

```asm
; @launch grid=(256,1,1) block=(576,1,1) lds=153600
.amdgcn_target "amdgcn-amd-amdhsa--gfx950"
.text
.globl recurrent_scan__sliding_block_cached__glu_gated_reglu__decode_kernel
.p2align 8
.type recurrent_scan__sliding_block_cached__glu_gated_reglu__decode_kernel,@function
recurrent_scan__sliding_block_cached__glu_gated_reglu__decode_kernel:
    s_load_dwordx16 s[4:19], s[0:1], 0
    s_load_dwordx8 s[20:27], s[0:1], 64
    s_cmp_ge_u32 s2, 256
    s_cbranch_scc1 L_end
    s_mov_b32 s28, s2
    v_lshrrev_b32 v4, 6, v0
    v_and_b32 v1, 63, v0
    v_readfirstlane_b32 s29, v4
    v_bfe_u32 v2, v0, 4, 2
    v_and_b32 v3, 15, v0
    s_mov_b32 s40, 5000
    s_and_b32 s37, s28, 7
    s_lshl_b32 s37, s37, 1
    s_bfe_u32 s38, s28, 0x10003
    s_or_b32 s37, s37, s38
    s_and_b32 s38, s28, 0xf0
    s_or_b32 s50, s37, s38
    s_and_b32 s37, s28, 7
    s_bfe_u32 s38, s28, 0x40003
    s_lshl4_add_u32 s39, s37, s38
    s_and_b32 s38, s38, 3
    s_lshl2_add_u32 s37, s37, s38
    s_and_b32 s38, s28, 0xe0
    s_or_b32 s52, s37, s38
    s_cmp_lt_u32 s28, 128
    s_cselect_b32 s50, s39, s50
    s_cselect_b32 s48, s28, s39
    s_movk_i32 s36, 3584
    s_cmp_lt_u32 s28, 128
    s_cselect_b32 s36, 8192, s36
    v_lshrrev_b32 v4, 2, v1
    v_mul_u32_u24 v12, s36, v4
    v_and_b32 v4, 3, v1
    v_lshl_add_u32 v12, v4, 4, v12
    s_lshl_b32 s37, s29, 10
    v_lshl_add_u32 v13, v1, 4, s37
    s_lshl_b32 s49, s29, 13
    s_lshl_b32 s39, s29, 12
    s_add_u32 s39, s39, 65536
    s_mov_b32 m0, s39
    s_lshl_b32 s38, s29, 6
    s_mul_i32 s38, s38, s36
    s_cmp_lt_u32 s50, 184
    s_cselect_b32 s37, 0, 56
    s_and_b32 s39, s50, 127
    s_sub_u32 s37, s39, s37
    s_lshl_b32 s37, s37, 6
    s_add_u32 s38, s38, s37
    s_lshl_b32 s39, s36, 4
    s_sub_u32 s39, s39, 1024
    s_waitcnt lgkmcnt(0)
    s_load_dword s30, s[26:27], 0
    s_cmp_eq_u32 s29, 8
    s_cbranch_scc1 L_service
    s_cmp_ge_u32 s28, 240
    s_cbranch_scc1 L_now1
    global_load_dwordx4 v[8:11], v13, s[4:5]
    s_cmp_lt_u32 s50, 184
    s_cselect_b64 s[32:33], s[16:17], s[18:19]
    s_cmp_lt_u32 s28, 128
    s_cselect_b64 s[32:33], s[10:11], s[32:33]
    s_add_u32 s32, s32, s38
    s_addc_u32 s33, s33, 0
    global_load_lds_dwordx4 v12, s[32:33] offset:0
    v_add_u32 v12, s39, v12
    global_load_lds_dwordx4 v12, s[32:33] offset:1024
    v_add_u32 v12, s39, v12
    global_load_lds_dwordx4 v12, s[32:33] offset:2048
    v_add_u32 v12, s39, v12
    global_load_lds_dwordx4 v12, s[32:33] offset:3072
L_now1:
    s_lshr_b32 s37, s52, 2
    s_lshl_b32 s37, s37, 20
    s_and_b32 s38, s52, 3
    s_lshl_b32 s38, s38, 16
    s_add_u32 s37, s37, s38
    s_add_u32 s37, s37, 786432
    s_add_u32 s6, s6, s37
    s_addc_u32 s7, s7, 0
    s_add_u32 s8, s8, s37
    s_addc_u32 s9, s9, 0
    v_xor_b32 v16, v3, v2
    v_lshlrev_b32 v16, 4, v16
    v_lshl_add_u32 v16, v2, 8, v16
    s_lshr_b32 s51, s29, 2
    s_lshl_b32 s38, s29, 1
    s_or_b32 s51, s51, s38
    s_bfe_u32 s38, s28, 0x30003
    s_xor_b32 s51, s51, s38
    s_lshl_b32 s51, s51, 12
    v_or_b32 v16, s51, v16
    v_xor_b32 v17, 64, v16
    v_xor_b32 v18, 0x80, v16
    v_xor_b32 v19, 0xc0, v16
    s_mov_b32 m0, s49
    s_cmp_ge_u32 s28, 240
    s_cbranch_scc1 L_p1skip0
    s_waitcnt vmcnt(4)
    v_lshlrev_b32 v96, 16, v8
    v_and_b32 v97, 0xffff0000, v8
    v_lshlrev_b32 v98, 16, v9
    v_and_b32 v99, 0xffff0000, v9
    v_lshlrev_b32 v100, 16, v10
    v_and_b32 v101, 0xffff0000, v10
    v_lshlrev_b32 v102, 16, v11
    v_and_b32 v103, 0xffff0000, v11
    v_pk_add_f32 v[4:5], v[96:97], v[98:99]
    v_pk_add_f32 v[6:7], v[100:101], v[102:103]
    v_pk_add_f32 v[4:5], v[4:5], v[6:7]
    v_add_f32 v4, v4, v5
    s_nop 1
    v_add_f32_dpp v4, v4, v4 quad_perm:[1,0,3,2] row_mask:0xf bank_mask:0xf
    s_nop 1
    v_add_f32_dpp v4, v4, v4 quad_perm:[2,3,0,1] row_mask:0xf bank_mask:0xf
    s_nop 1
    v_add_f32_dpp v4, v4, v4 row_half_mirror row_mask:0xf bank_mask:0xf
    s_nop 1
    v_add_f32_dpp v4, v4, v4 row_mirror row_mask:0xf bank_mask:0xf
    v_mov_b32 v5, v4
    s_nop 1
    v_permlane16_swap_b32 v4, v5
    s_nop 0
    v_add_f32 v4, v4, v5
    v_mov_b32 v5, v4
    s_nop 1
    v_permlane32_swap_b32 v4, v5
    s_nop 0
    v_add_f32 v4, v4, v5
    v_mul_f32 v4, 0x3b000000, v4
    v_sub_f32 v5, v96, v4
    v_mul_f32 v6, v5, v5
    v_sub_f32 v5, v97, v4
    v_fmac_f32 v6, v5, v5
    v_sub_f32 v5, v98, v4
    v_fmac_f32 v6, v5, v5
    v_sub_f32 v5, v99, v4
    v_fmac_f32 v6, v5, v5
    v_sub_f32 v5, v100, v4
    v_fmac_f32 v6, v5, v5
    v_sub_f32 v5, v101, v4
    v_fmac_f32 v6, v5, v5
    v_sub_f32 v5, v102, v4
    v_fmac_f32 v6, v5, v5
    v_sub_f32 v5, v103, v4
    v_fmac_f32 v6, v5, v5
    s_nop 1
    v_add_f32_dpp v6, v6, v6 quad_perm:[1,0,3,2] row_mask:0xf bank_mask:0xf
    s_nop 1
    v_add_f32_dpp v6, v6, v6 quad_perm:[2,3,0,1] row_mask:0xf bank_mask:0xf
    s_nop 1
    v_add_f32_dpp v6, v6, v6 row_half_mirror row_mask:0xf bank_mask:0xf
    s_nop 1
    v_add_f32_dpp v6, v6, v6 row_mirror row_mask:0xf bank_mask:0xf
    v_mov_b32 v5, v6
    s_nop 1
    v_permlane16_swap_b32 v6, v5
    s_nop 0
    v_add_f32 v6, v6, v5
    v_mov_b32 v5, v6
    s_nop 1
    v_permlane32_swap_b32 v6, v5
    s_nop 0
    v_add_f32 v6, v6, v5
    v_mul_f32 v6, 0x3b000000, v6
    v_cvt_pk_bf16_f32 v4, 0, v4
    v_cvt_pk_bf16_f32 v6, 0, v6
    v_add_f32 v6, 0x3727c5ac, v6
    v_cvt_pk_bf16_f32 v6, 0, v6
    v_sqrt_f32 v6, v6
    s_nop 0
    v_cvt_pk_bf16_f32 v6, 0, v6
    v_rcp_f32 v6, v6
    v_sub_f32 v96, v96, v4
    v_sub_f32 v97, v97, v4
    v_sub_f32 v98, v98, v4
    v_sub_f32 v99, v99, v4
    v_sub_f32 v100, v100, v4
    v_sub_f32 v101, v101, v4
    v_sub_f32 v102, v102, v4
    v_sub_f32 v103, v103, v4
    v_cvt_pk_bf16_f32 v8, v96, v97
    v_lshlrev_b32 v96, 16, v8
    v_and_b32 v97, 0xffff0000, v8
    v_mul_f32 v96, v96, v6
    v_mul_f32 v97, v97, v6
    v_cvt_pk_bf16_f32 v8, v96, v97
    v_cvt_pk_bf16_f32 v9, v98, v99
    v_lshlrev_b32 v98, 16, v9
    v_and_b32 v99, 0xffff0000, v9
    v_mul_f32 v98, v98, v6
    v_mul_f32 v99, v99, v6
    v_cvt_pk_bf16_f32 v9, v98, v99
    v_cvt_pk_bf16_f32 v10, v100, v101
    v_lshlrev_b32 v100, 16, v10
    v_and_b32 v101, 0xffff0000, v10
    v_mul_f32 v100, v100, v6
    v_mul_f32 v101, v101, v6
    v_cvt_pk_bf16_f32 v10, v100, v101
    v_cvt_pk_bf16_f32 v11, v102, v103
    v_lshlrev_b32 v102, 16, v11
    v_and_b32 v103, 0xffff0000, v11
    v_mul_f32 v102, v102, v6
    v_mul_f32 v103, v103, v6
    v_cvt_pk_bf16_f32 v11, v102, v103
    s_mul_i32 s37, s29, 1040
    s_add_u32 s37, s37, 106496
    v_lshl_add_u32 v4, v1, 4, s37
    ds_write_b128 v4, v[8:11]
    v_and_b32 v5, 7, v3
    v_mul_u32_u24 v4, 1040, v5
    v_lshl_add_u32 v4, v2, 4, v4
    s_lshl_b32 s37, s29, 7
    s_add_u32 s37, s37, 106496
    v_add_u32 v4, s37, v4
    v_mov_b32 v5, 120512
    v_cmp_gt_u32 vcc, 8, v3
    s_lshl_b32 s37, s29, 12
    s_add_u32 s37, s37, 65536
    v_cndmask_b32 v6, v5, v4, vcc
    v_cndmask_b32 v7, v4, v5, vcc
    v_lshrrev_b32 v4, 2, v3
    v_lshl_add_u32 v4, v2, 3, v4
    v_and_b32 v5, 3, v3
    v_lshlrev_b32 v5, 3, v5
    v_lshl_add_u32 v5, v4, 6, v5
    v_add_u32 v5, s37, v5
    s_lshl_b32 s37, s29, 10
    s_add_u32 s37, s37, 98304
    v_lshl_add_u32 v4, v1, 4, s37
    s_waitcnt lgkmcnt(0)
    s_barrier
    ds_read_b128 v[128:131], v6 offset:0
    ds_read_b128 v[132:135], v7 offset:0
    ds_read_b128 v[136:139], v6 offset:64
    ds_read_b128 v[140:143], v7 offset:64
    global_load_lds_dwordx4 v16, s[6:7] offset:0 nt
    global_load_lds_dwordx4 v17, s[6:7] offset:1024 nt
    global_load_lds_dwordx4 v18, s[6:7] offset:2048 nt
    global_load_lds_dwordx4 v19, s[6:7] offset:3072 nt
    s_waitcnt vmcnt(4)
    ds_read_b64_tr_b16 v[96:97], v5 offset:0
    ds_read_b64_tr_b16 v[98:99], v5 offset:256
    ds_read_b64_tr_b16 v[100:101], v5 offset:32
    ds_read_b64_tr_b16 v[102:103], v5 offset:288
    ds_read_b64_tr_b16 v[104:105], v5 offset:2048
    ds_read_b64_tr_b16 v[106:107], v5 offset:2304
    ds_read_b64_tr_b16 v[108:109], v5 offset:2080
    ds_read_b64_tr_b16 v[110:111], v5 offset:2336
    s_waitcnt lgkmcnt(0)
    v_mfma_f32_16x16x32_bf16 v[8:11], v[96:99], v[128:131], 0
    v_mfma_f32_16x16x32_bf16 v[8:11], v[100:103], v[132:135], v[8:11]
    v_mfma_f32_16x16x32_bf16 v[8:11], v[104:107], v[136:139], v[8:11]
    v_mfma_f32_16x16x32_bf16 v[8:11], v[108:111], v[140:143], v[8:11]
    s_nop 7
    ds_write_b128 v4, v[8:11]
    s_waitcnt lgkmcnt(0)
    s_barrier
    s_barrier
    s_branch L_p1skip
L_p1skip0:
    global_load_lds_dwordx4 v16, s[6:7] offset:0 nt
    global_load_lds_dwordx4 v17, s[6:7] offset:1024 nt
    global_load_lds_dwordx4 v18, s[6:7] offset:2048 nt
    global_load_lds_dwordx4 v19, s[6:7] offset:3072 nt
L_p1skip:
    s_setprio 2
    s_add_u32 s39, s49, 4096
    s_mov_b32 m0, s39
    v_xor_b32 v16, 0x1000, v16
    v_xor_b32 v17, 0x1000, v17
    v_xor_b32 v18, 0x1000, v18
    v_xor_b32 v19, 0x1000, v19
    global_load_lds_dwordx4 v16, s[6:7] offset:0 nt
    global_load_lds_dwordx4 v17, s[6:7] offset:1024 nt
    global_load_lds_dwordx4 v18, s[6:7] offset:2048 nt
    global_load_lds_dwordx4 v19, s[6:7] offset:3072 nt
    s_setprio 0
    v_lshlrev_b32 v59, 10, v2
    v_lshl_add_u32 v59, v3, 4, v59
    v_xor_b32 v59, s51, v59
    v_xor_b32 v60, 0x1000, v59
    s_sub_u32 s38, s28, 56
    s_cmp_lt_u32 s38, 72
    s_cselect_b32 s31, 0, 1
    s_cmp_lt_u32 s28, 128
    s_cselect_b64 s[34:35], s[20:21], s[12:13]
    s_mov_b32 s53, 1048576
    s_cselect_b32 s53, 2097152, s53
    s_lshr_b32 s38, s48, 2
    s_lshl_b32 s37, s38, 17
    s_lshl_b32 s38, s38, 8
    s_add_u32 s53, s53, s38
    s_lshl_b32 s38, s29, 14
    s_add_u32 s37, s37, s38
    s_and_b32 s38, s48, 3
    s_lshl_b32 s39, s38, 8
    s_add_u32 s37, s37, s39
    s_add_u32 s34, s34, s37
    s_addc_u32 s35, s35, 0
    v_lshlrev_b32 v4, 1, v2
    v_xor_b32 v4, v4, v3
    v_lshlrev_b32 v4, 4, v4
    v_lshl_add_u32 v25, v2, 10, v4
    s_lshl_b32 s39, s29, 12
    s_add_u32 s39, s39, 120832
    s_mov_b32 m0, s39
    global_load_dwordx4 v[64:67], v59, s[8:9] offset:0 nt
    global_load_dwordx4 v[68:71], v59, s[8:9] offset:256 nt
    s_mov_b32 s41, 0x05040100
    s_mov_b32 s42, 0x07060302
    s_waitcnt lgkmcnt(0)
    s_mul_i32 s30, s30, 0x9E3779B1
    s_add_u32 s30, s30, 0x7F4A7C15
    s_add_u32 s54, s26, 3145728
    s_addc_u32 s55, s27, 0
    s_mov_b64 s[56:57], s[54:55]
    s_and_b32 s38, s48, 3
    s_lshl_b32 s38, s38, 15
    s_add_u32 s53, s53, s38
    s_lshr_b32 s38, s29, 1
    s_lshl_b32 s38, s38, 13
    s_add_u32 s53, s53, s38
    s_and_b32 s38, s29, 1
    s_lshl_b32 s38, s38, 7
    s_add_u32 s53, s53, s38
    v_and_b32 v4, 7, v3
    v_lshl_add_u32 v26, v4, 17, s53
    v_lshl_add_u32 v26, v2, 5, v26
    v_lshrrev_b32 v5, 3, v3
    v_lshl_add_u32 v26, v5, 4, v26
    v_mul_u32_u24 v28, 272, v4
    v_lshl_add_u32 v28, v2, 4, v28
    v_add_u32 v28, 118080, v28
    v_lshrrev_b32 v4, 2, v3
    v_bfe_u32 v5, v3, 1, 1
    s_lshl_b32 s38, s29, 1
    v_or_b32 v5, s38, v5
    v_lshlrev_b32 v6, 1, v4
    v_xor_b32 v5, v5, v6
    v_and_b32 v6, 1, v2
    v_lshlrev_b32 v6, 3, v6
    v_xor_b32 v5, v5, v6
    v_lshl_add_u32 v4, v2, 3, v4
    v_lshlrev_b32 v4, 8, v4
    v_lshl_add_u32 v27, v5, 4, v4
    v_and_b32 v4, 1, v3
    v_lshl_add_u32 v27, v4, 3, v27
    v_add_u32 v27, 120832, v27
    v_cmp_lt_u32 s[46:47], 7, v3
    v_xor_b32 v16, v3, v2
    v_lshlrev_b32 v16, 4, v16
    v_lshl_add_u32 v16, v3, 8, v16
    v_add_u32 v16, s49, v16
    v_xor_b32 v17, 64, v16
    v_xor_b32 v18, 0x80, v16
    v_xor_b32 v19, 0xc0, v16
    v_and_b32 v22, 3, v3
    v_mul_u32_u24 v23, 272, v22
    v_lshl_add_u32 v23, v2, 4, v23
    v_add_u32 v23, 114816, v23
    v_lshlrev_b32 v4, 5, v22
    s_lshl_b32 s39, s29, 2
    v_add_u32 v24, 120256, v4
    v_add_u32 v29, s39, v24
    s_lshr_b32 s37, s48, 2
    s_lshl_b32 s37, s37, 3
    s_add_u32 s37, s37, s29
    s_lshl_b32 s38, s37, 5
    s_add_u32 s38, s38, 262144
    v_mov_b32 v57, s38
    s_lshl_b32 s38, s37, 11
    s_add_u32 s38, s38, 327680
    v_lshl_add_u32 v56, v1, 3, s38
    v_bfe_u32 v4, v1, 3, 2
    v_lshlrev_b32 v58, 6, v4
    v_and_b32 v4, 3, v1
    v_lshl_add_u32 v58, v4, 4, v58
    v_lshrrev_b32 v4, 5, v1
    v_lshl_add_u32 v58, v4, 3, v58
    v_and_b32 v4, 4, v1
    s_mul_i32 s37, s29, 272
    s_add_u32 s37, s37, 118080
    v_add3_u32 v58, v58, v4, s37
    s_lshl_b32 s37, s29, 11
    s_add_u32 s37, s37, 65536
    v_lshl_add_u32 v30, v1, 4, s37
    v_lshlrev_b32 v31, 2, v0
    v_add_u32 v31, 65536, v31
    v_bfe_u32 v4, v1, 2, 2
    v_lshlrev_b32 v20, 14, v4
    v_lshrrev_b32 v4, 5, v1
    v_lshl_add_u32 v20, v4, 5, v20
    v_and_b32 v4, 3, v1
    v_lshl_add_u32 v20, v4, 3, v20
    s_bfe_u32 s37, s52, 0x30002
    s_lshl_b32 s37, s37, 16
    s_lshr_b32 s38, s52, 5
    s_lshl_b32 s38, s38, 11
    s_add_u32 s37, s37, s38
    s_and_b32 s38, s52, 3
    s_lshl_b32 s38, s38, 9
    s_add_u32 s37, s37, s38
    s_lshl_b32 s38, s29, 6
    s_add_u32 s37, s37, s38
    s_add_u32 s37, s37, 327680
    v_add_u32 v20, s37, v20
    s_barrier
    global_load_dwordx4 v[72:75], v59, s[8:9] offset:512 nt
    global_load_dwordx4 v[76:79], v59, s[8:9] offset:768 nt
    global_load_dwordx4 v[80:83], v60, s[8:9] offset:0 nt
    s_waitcnt vmcnt(5)
    ds_read_b128 v[96:99], v16 offset:0
    ds_read_b128 v[100:103], v17 offset:0
    ds_read_b128 v[104:107], v18 offset:0
    ds_read_b128 v[108:111], v19 offset:0
    ds_read_b128 v[112:115], v16 offset:4096
    ds_read_b128 v[116:119], v17 offset:4096
    ds_read_b128 v[120:123], v18 offset:4096
    ds_read_b128 v[124:127], v19 offset:4096
    s_mov_b32 s37, 0x3db504f3
    s_mov_b32 s38, 0x3fb8aa3b
    s_barrier
    ds_read_b128 v[128:131], v23 offset:0
    ds_read_b128 v[132:135], v23 offset:64
    ds_read_b128 v[136:139], v23 offset:128
    ds_read_b128 v[140:143], v23 offset:192
    s_waitcnt lgkmcnt(0)
    v_mfma_f32_16x16x32_bf16 v[144:147], v[96:99], v[128:131], 0
    v_mfma_f32_16x16x32_bf16 v[148:151], v[112:115], v[128:131], 0
    v_mfma_f32_16x16x32_bf16 v[144:147], v[100:103], v[132:135], v[144:147]
    v_mfma_f32_16x16x32_bf16 v[148:151], v[116:119], v[132:135], v[148:151]
    v_mfma_f32_16x16x32_bf16 v[144:147], v[104:107], v[136:139], v[144:147]
    v_mfma_f32_16x16x32_bf16 v[148:151], v[120:123], v[136:139], v[148:151]
    v_mfma_f32_16x16x32_bf16 v[144:147], v[108:111], v[140:143], v[144:147]
    v_mfma_f32_16x16x32_bf16 v[148:151], v[124:127], v[140:143], v[148:151]
    global_load_dwordx4 v[84:87], v60, s[8:9] offset:256 nt
    global_load_dwordx4 v[88:91], v60, s[8:9] offset:512 nt
    global_load_dwordx4 v[92:95], v60, s[8:9] offset:768 nt
    s_nop 7
    v_cvt_pk_bf16_f32 v8, v144, v145
    v_cvt_pk_bf16_f32 v9, v146, v147
    v_cvt_pk_bf16_f32 v10, v148, v149
    v_cvt_pk_bf16_f32 v11, v150, v151
    v_lshlrev_b32 v144, 16, v8
    v_and_b32 v145, 0xffff0000, v8
    v_lshlrev_b32 v146, 16, v9
    v_and_b32 v147, 0xffff0000, v9
    v_lshlrev_b32 v148, 16, v10
    v_and_b32 v149, 0xffff0000, v10
    v_lshlrev_b32 v150, 16, v11
    v_and_b32 v151, 0xffff0000, v11
    v_mul_f32 v144, s37, v144
    v_mul_f32 v145, s37, v145
    v_mul_f32 v146, s37, v146
    v_mul_f32 v147, s37, v147
    v_mul_f32 v148, s37, v148
    v_mul_f32 v149, s37, v149
    v_mul_f32 v150, s37, v150
    v_mul_f32 v151, s37, v151
    v_cvt_pk_bf16_f32 v8, v144, v145
    v_cvt_pk_bf16_f32 v9, v146, v147
    v_cvt_pk_bf16_f32 v10, v148, v149
    v_cvt_pk_bf16_f32 v11, v150, v151
    v_lshlrev_b32 v144, 16, v8
    v_and_b32 v145, 0xffff0000, v8
    v_lshlrev_b32 v146, 16, v9
    v_and_b32 v147, 0xffff0000, v9
    v_lshlrev_b32 v148, 16, v10
    v_and_b32 v149, 0xffff0000, v10
    v_lshlrev_b32 v150, 16, v11
    v_and_b32 v151, 0xffff0000, v11
    v_max3_f32 v6, v144, v145, v146
    v_max3_f32 v7, v147, v148, v149
    v_max3_f32 v6, v6, v150, v151
    v_max_f32 v6, v6, v7
    v_mov_b32 v7, v6
    s_nop 1
    v_permlane16_swap_b32 v6, v7
    s_nop 0
    v_max_f32 v6, v6, v7
    v_mov_b32 v7, v6
    s_nop 1
    v_permlane32_swap_b32 v6, v7
    s_nop 0
    v_max_f32 v6, v6, v7
    v_mul_f32 v23, s38, v6
    v_fma_f32 v144, v144, s38, -v23
    v_fma_f32 v145, v145, s38, -v23
    v_fma_f32 v146, v146, s38, -v23
    v_fma_f32 v147, v147, s38, -v23
    v_fma_f32 v148, v148, s38, -v23
    v_fma_f32 v149, v149, s38, -v23
    v_fma_f32 v150, v150, s38, -v23
    v_fma_f32 v151, v151, s38, -v23
    v_exp_f32 v144, v144
    v_exp_f32 v145, v145
    v_exp_f32 v146, v146
    v_exp_f32 v147, v147
    v_exp_f32 v148, v148
    v_exp_f32 v149, v149
    v_exp_f32 v150, v150
    v_exp_f32 v151, v151
    s_nop 0
    v_pk_add_f32 v[4:5], v[144:145], v[146:147]
    v_pk_add_f32 v[6:7], v[148:149], v[150:151]
    v_pk_add_f32 v[4:5], v[4:5], v[6:7]
    v_add_f32 v7, v4, v5
    v_mov_b32 v8, v7
    s_nop 1
    v_permlane16_swap_b32 v7, v8
    s_nop 0
    v_add_f32 v7, v7, v8
    v_mov_b32 v8, v7
    s_nop 1
    v_permlane32_swap_b32 v7, v8
    s_nop 0
    v_add_f32 v7, v7, v8
    s_mov_b64 exec, 15
    ds_write2_b32 v29, v23, v7 offset0:0 offset1:32
    s_mov_b64 exec, -1
    s_waitcnt lgkmcnt(0)
    s_barrier
    ds_read_b128 v[8:11], v24
    ds_read_b128 v[12:15], v24 offset:16
    ds_read_b128 v[128:131], v24 offset:128
    ds_read_b128 v[132:135], v24 offset:144
    s_waitcnt lgkmcnt(0)
    v_max3_f32 v6, v8, v9, v10
    v_max3_f32 v7, v11, v12, v13
    v_max3_f32 v6, v6, v14, v15
    v_max_f32 v6, v6, v7
    v_sub_f32 v8, v8, v6
    v_sub_f32 v9, v9, v6
    v_sub_f32 v10, v10, v6
    v_sub_f32 v11, v11, v6
    v_sub_f32 v12, v12, v6
    v_sub_f32 v13, v13, v6
    v_sub_f32 v14, v14, v6
    v_sub_f32 v15, v15, v6
    v_exp_f32 v8, v8
    v_exp_f32 v9, v9
    v_exp_f32 v10, v10
    v_exp_f32 v11, v11
    v_exp_f32 v12, v12
    v_exp_f32 v13, v13
    v_exp_f32 v14, v14
    v_exp_f32 v15, v15
    v_mul_f32 v7, v8, v128
    v_fmac_f32 v7, v9, v129
    v_fmac_f32 v7, v10, v130
    v_fmac_f32 v7, v11, v131
    v_fmac_f32 v7, v12, v132
    v_fmac_f32 v7, v13, v133
    v_fmac_f32 v7, v14, v134
    v_fmac_f32 v7, v15, v135
    v_sub_f32 v23, v23, v6
    v_rcp_f32 v8, v7
    v_exp_f32 v23, v23
    v_lshrrev_b32 v4, 2, v3
    v_mul_f32 v23, v23, v8
    v_mul_f32 v144, v23, v144
    v_mul_f32 v145, v23, v145
    v_mul_f32 v146, v23, v146
    v_mul_f32 v147, v23, v147
    v_mul_f32 v148, v23, v148
    v_mul_f32 v149, v23, v149
    v_mul_f32 v150, v23, v150
    v_mul_f32 v151, v23, v151
    v_cvt_pk_bf16_f32 v144, v144, v145
    v_cvt_pk_bf16_f32 v145, v146, v147
    v_cvt_pk_bf16_f32 v146, v148, v149
    v_cvt_pk_bf16_f32 v147, v150, v151
    v_mov_b32 v148, 0
    v_mov_b32 v149, 0
    v_mov_b32 v150, 0
    v_mov_b32 v151, 0
    v_mov_b32 v152, 0
    v_mov_b32 v153, 0
    v_mov_b32 v154, 0
    v_mov_b32 v155, 0
    v_mov_b32 v156, 0
    v_mov_b32 v157, 0
    v_mov_b32 v158, 0
    v_mov_b32 v159, 0
    v_mov_b32 v160, 0
    v_mov_b32 v161, 0
    v_mov_b32 v162, 0
    v_mov_b32 v163, 0
    s_mov_b32 exec_lo, 0xf000f
    s_mov_b32 exec_hi, 0xf000f
    v_pk_mov_b32 v[148:149], v[144:145], v[144:145] op_sel:[0,1]
    v_pk_mov_b32 v[150:151], v[146:147], v[146:147] op_sel:[0,1]
    s_mov_b32 exec_lo, 0xf000f0
    s_mov_b32 exec_hi, 0xf000f0
    v_pk_mov_b32 v[152:153], v[144:145], v[144:145] op_sel:[0,1]
    v_pk_mov_b32 v[154:155], v[146:147], v[146:147] op_sel:[0,1]
    s_mov_b32 exec_lo, 0xf000f00
    s_mov_b32 exec_hi, 0xf000f00
    v_pk_mov_b32 v[156:157], v[144:145], v[144:145] op_sel:[0,1]
    v_pk_mov_b32 v[158:159], v[146:147], v[146:147] op_sel:[0,1]
    s_mov_b32 exec_lo, 0xf000f000
    s_mov_b32 exec_hi, 0xf000f000
    v_pk_mov_b32 v[160:161], v[144:145], v[144:145] op_sel:[0,1]
    v_pk_mov_b32 v[162:163], v[146:147], v[146:147] op_sel:[0,1]
    s_mov_b64 exec, -1
    v_mov_b32 v7, s30
    s_cmp_lg_u32 s31, 0
    s_cbranch_scc0 L_now33
    global_load_lds_dwordx4 v25, s[34:35] offset:0
    v_add_u32 v25, 3072, v25
    global_load_lds_dwordx4 v25, s[34:35] offset:1024
    v_add_u32 v25, 3072, v25
    v_xor_b32 v25, 0x80, v25
    global_load_lds_dwordx4 v25, s[34:35] offset:2048
    v_add_u32 v25, 3072, v25
    global_load_lds_dwordx4 v25, s[34:35] offset:3072
L_now33:
    s_cmp_lg_u32 s31, 0
    s_cbranch_scc1 L_vw0
    s_waitcnt vmcnt(6)
L_vw0:
    s_waitcnt vmcnt(10)
    v_perm_b32 v96, v68, v64, s41
    v_perm_b32 v100, v68, v64, s42
    v_perm_b32 v104, v69, v65, s41
    v_perm_b32 v108, v69, v65, s42
    v_perm_b32 v112, v70, v66, s41
    v_perm_b32 v116, v70, v66, s42
    v_perm_b32 v120, v71, v67, s41
    v_perm_b32 v124, v71, v67, s42
    s_cbranch_scc1 L_vw1
    s_waitcnt vmcnt(4)
L_vw1:
    s_waitcnt vmcnt(8)
    v_perm_b32 v97, v76, v72, s41
    v_perm_b32 v101, v76, v72, s42
    v_perm_b32 v105, v77, v73, s41
    v_perm_b32 v109, v77, v73, s42
    v_perm_b32 v113, v78, v74, s41
    v_perm_b32 v117, v78, v74, s42
    v_perm_b32 v121, v79, v75, s41
    v_perm_b32 v125, v79, v75, s42
    s_cbranch_scc1 L_vw2
    s_waitcnt vmcnt(2)
L_vw2:
    s_waitcnt vmcnt(6)
    v_perm_b32 v98, v84, v80, s41
    v_perm_b32 v102, v84, v80, s42
    v_perm_b32 v106, v85, v81, s41
    v_perm_b32 v110, v85, v81, s42
    v_perm_b32 v114, v86, v82, s41
    v_perm_b32 v118, v86, v82, s42
    v_perm_b32 v122, v87, v83, s41
    v_perm_b32 v126, v87, v83, s42
    s_cbranch_scc1 L_vw3
    s_waitcnt vmcnt(0)
L_vw3:
    s_waitcnt vmcnt(4)
    v_perm_b32 v99, v92, v88, s41
    v_perm_b32 v103, v92, v88, s42
    v_perm_b32 v107, v93, v89, s41
    v_perm_b32 v111, v93, v89, s42
    v_perm_b32 v115, v94, v90, s41
    v_perm_b32 v119, v94, v90, s42
    v_perm_b32 v123, v95, v91, s41
    v_perm_b32 v127, v95, v91, s42
    v_mfma_f32_16x16x32_bf16 v[128:131], v[96:99], v[148:151], 0
    v_mfma_f32_16x16x32_bf16 v[128:131], v[100:103], v[152:155], v[128:131]
    v_mfma_f32_16x16x32_bf16 v[128:131], v[104:107], v[156:159], v[128:131]
    v_mfma_f32_16x16x32_bf16 v[128:131], v[108:111], v[160:163], v[128:131]
    v_mfma_f32_16x16x32_bf16 v[132:135], v[112:115], v[148:151], 0
    v_mfma_f32_16x16x32_bf16 v[132:135], v[116:119], v[152:155], v[132:135]
    v_mfma_f32_16x16x32_bf16 v[132:135], v[120:123], v[156:159], v[132:135]
    v_mfma_f32_16x16x32_bf16 v[132:135], v[124:127], v[160:163], v[132:135]
    s_nop 3
    ds_write_b128 v30, v[128:131]
    s_nop 2
    ds_write_b128 v30, v[132:135] offset:1024
    s_waitcnt lgkmcnt(0)
    s_barrier
    ds_read2st64_b32 v[8:9], v31 offset0:0 offset1:8
    ds_read2st64_b32 v[10:11], v31 offset0:16 offset1:24
    ds_read2st64_b32 v[12:13], v31 offset0:32 offset1:40
    ds_read2st64_b32 v[14:15], v31 offset0:48 offset1:56
    s_waitcnt lgkmcnt(0)
    v_pk_add_f32 v[8:9], v[8:9], v[10:11]
    v_pk_add_f32 v[12:13], v[12:13], v[14:15]
    v_pk_add_f32 v[8:9], v[8:9], v[12:13]
    v_add_f32 v10, v8, v9
    v_add_f32 v11, v8, v9
    s_nop 1
    v_permlane16_swap_b32 v10, v11
    s_mov_b32 exec_lo, 0x0000FFFF
    s_mov_b32 exec_hi, 0x0000FFFF
    v_cvt_pk_bf16_f32 v6, v10, v11
    global_store_dwordx2 v20, v[6:7], s[54:55]
    s_mov_b64 exec, -1
    s_cmp_lt_u32 s28, 128
    s_cbranch_scc1 L_lo
L_lpoll:
    global_load_dwordx4 v[64:67], v57, s[56:57] offset:0 sc1
    global_load_dwordx4 v[68:71], v57, s[56:57] offset:16 sc1
    s_waitcnt vmcnt(0)
    v_min3_u32 v4, v65, v67, v67
    v_max3_u32 v5, v65, v67, v67
    v_min3_u32 v4, v4, v69, v71
    v_max3_u32 v5, v5, v69, v71
    v_cmp_ne_u32 vcc, s30, v4
    v_cmp_ne_u32 s[44:45], s30, v5
    s_or_b64 vcc, vcc, s[44:45]
    s_cbranch_scc0 L_lp_ok
    s_sub_u32 s40, s40, 1
    s_and_b32 s37, s40, 15
    s_cselect_b64 s[56:57], s[54:55], s[26:27]
    s_cbranch_scc1 L_ls1
    s_mov_b32 exec_lo, 0x0000FFFF
    s_mov_b32 exec_hi, 0x0000FFFF
    global_store_dwordx2 v20, v[6:7], s[26:27] sc1
    s_mov_b64 exec, -1
L_ls1:
    s_sleep 1
    s_cmp_gt_i32 s40, 0
    s_cbranch_scc1 L_lpoll
L_lp_ok:
    s_mov_b64 s[56:57], s[54:55]
    global_load_dwordx2 v[32:33], v56, s[56:57] offset:0 sc1
    global_load_dwordx2 v[34:35], v56, s[56:57] offset:512 sc1
    global_load_dwordx2 v[36:37], v56, s[56:57] offset:1024 sc1
    global_load_dwordx2 v[38:39], v56, s[56:57] offset:1536 sc1
    v_max3_f32 v4, v64, v66, v68
    v_max_f32 v4, v4, v70
    v_sub_f32 v8, v64, v4
    v_sub_f32 v9, v66, v4
    v_sub_f32 v10, v68, v4
    v_sub_f32 v11, v70, v4
    v_exp_f32 v8, v8
    v_exp_f32 v9, v9
    v_exp_f32 v10, v10
    v_exp_f32 v11, v11
    s_nop 0
    v_pk_add_f32 v[4:5], v[8:9], v[10:11]
    v_add_f32 v4, v4, v5
    v_rcp_f32 v4, v4
    s_nop 0
    v_mul_f32 v8, v8, v4
    v_mul_f32 v9, v9, v4
    v_mul_f32 v10, v10, v4
    v_mul_f32 v11, v11, v4
    s_branch L_op_in
L_op:
    global_load_dwordx2 v[32:33], v56, s[56:57] offset:0 sc1
    global_load_dwordx2 v[34:35], v56, s[56:57] offset:512 sc1
    global_load_dwordx2 v[36:37], v56, s[56:57] offset:1024 sc1
    global_load_dwordx2 v[38:39], v56, s[56:57] offset:1536 sc1
L_op_in:
    s_waitcnt vmcnt(0)
    v_min_u32 v4, v33, v35
    v_max_u32 v5, v33, v35
    v_min3_u32 v4, v4, v37, v39
    v_max3_u32 v5, v5, v37, v39
    v_cmp_ne_u32 vcc, s30, v4
    v_cmp_ne_u32 s[44:45], s30, v5
    s_or_b64 vcc, vcc, s[44:45]
    s_cbranch_scc0 L_op_0
    s_sleep 1
    s_sub_u32 s40, s40, 1
    s_and_b32 s37, s40, 15
    s_cselect_b64 s[56:57], s[54:55], s[26:27]
    s_cbranch_scc1 L_ls2
    s_mov_b32 exec_lo, 0x0000FFFF
    s_mov_b32 exec_hi, 0x0000FFFF
    global_store_dwordx2 v20, v[6:7], s[26:27] sc1
    s_mov_b64 exec, -1
L_ls2:
    s_cmp_gt_i32 s40, 0
    s_cbranch_scc1 L_op
L_op_0:
    v_and_b32 v33, 0xffff0000, v32
    v_lshlrev_b32 v32, 16, v32
    v_and_b32 v35, 0xffff0000, v34
    v_lshlrev_b32 v34, 16, v34
    v_and_b32 v37, 0xffff0000, v36
    v_lshlrev_b32 v36, 16, v36
    v_and_b32 v39, 0xffff0000, v38
    v_lshlrev_b32 v38, 16, v38
    v_pk_mul_f32 v[12:13], v[32:33], v[8:9] op_sel_hi:[1,0]
    v_pk_mul_f32 v[14:15], v[34:35], v[8:9] op_sel:[0,1] op_sel_hi:[1,1]
    v_pk_fma_f32 v[12:13], v[36:37], v[10:11], v[12:13] op_sel_hi:[1,0,1]
    v_pk_fma_f32 v[14:15], v[38:39], v[10:11], v[14:15] op_sel:[0,1,0] op_sel_hi:[1,1,1]
L_op_done:
    v_pk_add_f32 v[12:13], v[12:13], v[14:15]
    v_cvt_pk_bf16_f32 v12, v12, v13
    ds_write_b32 v58, v12
    s_mov_b32 exec_lo, 0x0000FFFF
    s_mov_b32 exec_hi, 0x0000FFFF
    global_store_dwordx2 v20, v[6:7], s[26:27] sc1
    s_mov_b64 exec, -1
    s_waitcnt lgkmcnt(0)
L_mf:
    s_barrier
    ds_read_b128 v[128:131], v28 offset:0
    ds_read_b128 v[132:135], v28 offset:64
    ds_read_b128 v[136:139], v28 offset:128
    ds_read_b128 v[140:143], v28 offset:192
    ds_read_b64_tr_b16 v[96:97], v27 offset:0
    ds_read_b64_tr_b16 v[98:99], v27 offset:1024
    ds_read_b64_tr_b16 v[100:101], v27 offset:8192
    ds_read_b64_tr_b16 v[102:103], v27 offset:9216
    ds_read_b64_tr_b16 v[104:105], v27 offset:16384
    ds_read_b64_tr_b16 v[106:107], v27 offset:17408
    ds_read_b64_tr_b16 v[108:109], v27 offset:24576
    ds_read_b64_tr_b16 v[110:111], v27 offset:25600
    v_mov_b32 v13, s30
    v_mov_b32 v15, s30
    s_waitcnt lgkmcnt(6)
    v_mfma_f32_16x16x32_bf16 v[8:11], v[96:99], v[128:131], 0
    s_waitcnt lgkmcnt(4)
    v_mfma_f32_16x16x32_bf16 v[8:11], v[100:103], v[132:135], v[8:11]
    s_waitcnt lgkmcnt(2)
    v_mfma_f32_16x16x32_bf16 v[8:11], v[104:107], v[136:139], v[8:11]
    s_waitcnt lgkmcnt(0)
    v_mfma_f32_16x16x32_bf16 v[8:11], v[108:111], v[140:143], v[8:11]
    s_nop 7
    v_cndmask_b32 v12, v8, v10, s[46:47]
    v_cndmask_b32 v14, v9, v11, s[46:47]
    global_store_dwordx4 v26, v[12:15], s[26:27] sc1
    s_cmp_lt_u32 s28, 128
    s_cbranch_scc1 L_final
    s_endpgm
L_lo:
    s_mov_b32 exec_lo, 0x0000FFFF
    s_mov_b32 exec_hi, 0x0000FFFF
    global_store_dwordx2 v20, v[6:7], s[26:27] sc1
    s_mov_b64 exec, -1
    s_cmp_ge_u32 s28, 56
    s_cbranch_scc1 L_final
    s_waitcnt vmcnt(2)
    s_branch L_mf
L_final:
    s_cmp_lg_u32 s29, 0
    s_cbranch_scc1 L_end
    s_lshl_b32 s37, s28, 13
    s_add_u32 s37, s37, 4096
    v_lshl_add_u32 v16, v1, 4, s37
    s_add_u32 s32, s26, 2097152
    s_addc_u32 s33, s27, 0
    s_add_u32 s34, s26, 1048576
    s_addc_u32 s35, s27, 0
    s_lshl_b32 s37, s28, 6
    v_lshl_add_u32 v17, v3, 2, s37
    global_load_dword v18, v17, s[4:5]
    v_mov_b32 v140, 0
    v_mov_b32 v141, s30
    v_mov_b32 v142, 0
    v_mov_b32 v143, s30
    v_lshlrev_b32 v6, 10, v2
    v_lshl_add_u32 v6, v3, 4, v6
    v_add_u32 v6, 266240, v6
L_fpoll:
    global_load_dwordx4 v[32:35], v6, s[26:27] offset:-4096 sc1
    global_load_dwordx4 v[36:39], v6, s[26:27] offset:0 sc1
    s_waitcnt vmcnt(0)
    v_min3_u32 v4, v33, v35, v35
    v_max3_u32 v5, v33, v35, v35
    v_min3_u32 v4, v4, v37, v39
    v_max3_u32 v5, v5, v37, v39
    v_cmp_ne_u32 vcc, s30, v4
    v_cmp_ne_u32 s[44:45], s30, v5
    s_or_b64 vcc, vcc, s[44:45]
    s_cbranch_scc0 L_fp_ok
    s_sub_u32 s40, s40, 1
    s_sleep 8
    s_cmp_gt_i32 s40, 0
    s_cbranch_scc1 L_fpoll
L_fp_ok:
L_dpoll:
    global_load_dwordx4 v[128:131], v16, s[32:33] offset:-4096 sc1
    global_load_dwordx4 v[132:135], v16, s[32:33] offset:-3072 sc1
    global_load_dwordx4 v[136:139], v16, s[32:33] offset:-2048 sc1
    s_mov_b32 exec_hi, 0
    global_load_dwordx4 v[140:143], v16, s[32:33] offset:-1024 sc1
    s_mov_b32 exec_hi, -1
    global_load_dwordx4 v[32:35], v16, s[34:35] offset:-4096 sc1
    global_load_dwordx4 v[36:39], v16, s[34:35] offset:-3072 sc1
    global_load_dwordx4 v[40:43], v16, s[34:35] offset:-2048 sc1
    global_load_dwordx4 v[44:47], v16, s[34:35] offset:-1024 sc1
    global_load_dwordx4 v[48:51], v16, s[34:35] offset:0 sc1
    global_load_dwordx4 v[52:55], v16, s[34:35] offset:1024 sc1
    global_load_dwordx4 v[56:59], v16, s[34:35] offset:2048 sc1
    global_load_dwordx4 v[60:63], v16, s[34:35] offset:3072 sc1
    s_waitcnt vmcnt(8)
    v_min3_u32 v4, v129, v131, v131
    v_max3_u32 v5, v129, v131, v131
    v_min3_u32 v4, v4, v133, v135
    v_max3_u32 v5, v5, v133, v135
    v_min3_u32 v4, v4, v137, v139
    v_max3_u32 v5, v5, v137, v139
    v_min3_u32 v4, v4, v141, v143
    v_max3_u32 v5, v5, v141, v143
    v_cmp_ne_u32 vcc, s30, v4
    v_cmp_ne_u32 s[44:45], s30, v5
    s_or_b64 vcc, vcc, s[44:45]
    s_cbranch_scc0 L_dp_ok
    s_sub_u32 s40, s40, 1
    s_sleep 4
    s_cmp_gt_i32 s40, 0
    s_cbranch_scc1 L_dpoll
L_dp_ok:
    v_add_f32 v8, v128, v132
    v_add_f32 v9, v130, v134
    v_add_f32 v10, v136, v140
    v_add_f32 v11, v138, v142
    v_pk_add_f32 v[8:9], v[8:9], v[10:11]
    s_nop 1
    v_permlane32_swap_b32 v8, v9
    s_nop 0
    v_add_f32 v8, v8, v9
    v_mov_b32 v9, v8
    s_nop 1
    v_permlane16_swap_b32 v8, v9
    s_nop 0
    v_add_f32 v8, v8, v9
    v_cvt_pk_bf16_f32 v8, 0, v8
    v_mul_f32 v10, 0xbfb8aa3b, v8
    v_exp_f32 v10, v10
    v_lshlrev_b32 v19, 16, v18
    v_add_f32 v10, 1.0, v10
    v_rcp_f32 v10, v10
    v_and_b32 v18, 0xffff0000, v18
    v_mul_f32 v20, v8, v10
    v_cvt_pk_bf16_f32 v20, 0, v20
    s_mov_b32 exec_hi, 0
    v_mov_b32 v18, v19
    s_mov_b32 exec_hi, -1
    v_lshrrev_b32 v4, 5, v1
    v_lshl_add_u32 v17, v4, 1, v17
    s_branch L_sp_in
L_sp:
    global_load_dwordx4 v[32:35], v16, s[34:35] offset:-4096 sc1
    global_load_dwordx4 v[36:39], v16, s[34:35] offset:-3072 sc1
    global_load_dwordx4 v[40:43], v16, s[34:35] offset:-2048 sc1
    global_load_dwordx4 v[44:47], v16, s[34:35] offset:-1024 sc1
    global_load_dwordx4 v[48:51], v16, s[34:35] offset:0 sc1
    global_load_dwordx4 v[52:55], v16, s[34:35] offset:1024 sc1
    global_load_dwordx4 v[56:59], v16, s[34:35] offset:2048 sc1
    global_load_dwordx4 v[60:63], v16, s[34:35] offset:3072 sc1
L_sp_in:
    s_waitcnt vmcnt(0)
    v_min_u32 v4, v33, v35
    v_max_u32 v5, v33, v35
    v_min3_u32 v4, v4, v37, v39
    v_max3_u32 v5, v5, v37, v39
    v_min3_u32 v4, v4, v41, v43
    v_max3_u32 v5, v5, v41, v43
    v_min3_u32 v4, v4, v45, v47
    v_max3_u32 v5, v5, v45, v47
    v_min3_u32 v4, v4, v49, v51
    v_max3_u32 v5, v5, v49, v51
    v_min3_u32 v4, v4, v53, v55
    v_max3_u32 v5, v5, v53, v55
    v_min3_u32 v4, v4, v57, v59
    v_max3_u32 v5, v5, v57, v59
    v_min3_u32 v4, v4, v61, v63
    v_max3_u32 v5, v5, v61, v63
    v_cmp_ne_u32 vcc, s30, v4
    v_cmp_ne_u32 s[44:45], s30, v5
    s_or_b64 vcc, vcc, s[44:45]
    s_cbranch_scc0 L_sp_0
    s_sleep 4
    s_sub_u32 s40, s40, 1
    s_cmp_gt_i32 s40, 0
    s_cbranch_scc1 L_sp
L_sp_0:
    v_add_f32 v8, v32, v36
    v_add_f32 v9, v34, v38
    v_add_f32 v10, v40, v44
    v_add_f32 v11, v42, v46
    v_add_f32 v8, v8, v48
    v_add_f32 v9, v9, v50
    v_add_f32 v10, v10, v52
    v_add_f32 v11, v11, v54
    v_add_f32 v8, v8, v56
    v_add_f32 v9, v9, v58
    v_add_f32 v10, v10, v60
    v_add_f32 v11, v11, v62
L_sp_done:
    v_pk_add_f32 v[8:9], v[8:9], v[10:11]
    s_nop 1
    v_permlane32_swap_b32 v8, v9
    s_nop 0
    v_add_f32 v8, v8, v9
    v_mov_b32 v9, v8
    s_nop 1
    v_permlane16_swap_b32 v8, v9
    s_nop 0
    v_add_f32 v8, v8, v9
    v_cvt_pk_bf16_f32 v8, 0, v8
    v_mul_f32 v8, v8, v20
    v_cvt_pk_bf16_f32 v8, 0, v8
    v_add_f32 v8, v8, v18
    v_cvt_pk_bf16_f32 v8, v8, v8
    s_mov_b32 exec_lo, 0xffff
    s_mov_b32 exec_hi, 0xffff
    global_store_short v17, v8, s[22:23]
    s_cmp_lg_u32 s28, 0
    s_cbranch_scc1 L_fin2
    s_mov_b64 exec, 1
    v_mov_b32 v4, 0
    v_mov_b32 v5, s30
    global_store_dword v4, v5, s[26:27]
L_fin2:
L_end:
    s_endpgm
L_service:
    s_setprio 3
    v_mov_b32 v8, 0
    v_and_b32 v4, 31, v1
    v_lshlrev_b32 v4, 2, v4
    v_add_u32 v4, 120512, v4
    ds_write_b32 v4, v8
    s_add_u32 s54, s26, 3145728
    s_addc_u32 s55, s27, 0
    s_mov_b64 s[56:57], s[54:55]
    s_lshr_b32 s37, s52, 5
    s_mul_i32 s37, s37, 30720
    s_bfe_u32 s38, s52, 0x30002
    s_lshl_b32 s38, s38, 11
    s_add_u32 s37, s37, s38
    s_add_u32 s37, s37, 4096
    v_lshl_add_u32 v16, v1, 4, s37
    s_add_u32 s32, s54, s37
    s_addc_u32 s33, s55, 0
    v_lshrrev_b32 v4, 5, v1
    v_mul_u32_u24 v17, 272, v4
    v_and_b32 v4, 31, v1
    v_lshl_add_u32 v17, v4, 3, v17
    v_add_u32 v17, 114816, v17
    s_lshr_b32 s37, s48, 2
    s_lshl_b32 s37, s37, 9
    s_add_u32 s37, s37, 24064
    v_lshrrev_b32 v5, 5, v1
    v_mul_u32_u24 v26, 30720, v5
    v_lshl_add_u32 v26, v4, 4, v26
    v_add_u32 v26, s37, v26
    v_add_u32 v27, 61440, v26
    v_add_u32 v28, 122880, v26
    v_add_u32 v29, 184320, v26
    v_add_u32 v20, 3264, v17
    v_lshlrev_b32 v21, 4, v1
    v_add_u32 v21, 98304, v21
    v_and_b32 v4, 7, v3
    v_mul_u32_u24 v22, 30720, v4
    v_lshrrev_b32 v4, 3, v3
    v_lshl_add_u32 v22, v4, 6, v22
    v_lshl_add_u32 v22, v2, 4, v22
    s_lshl_b32 s37, s50, 7
    s_add_u32 s37, s37, 4096
    v_add_u32 v22, s37, v22
    v_and_b32 v4, 3, v3
    v_lshlrev_b32 v24, 5, v4
    v_add_u32 v24, 120256, v24
    s_bfe_u32 s37, s52, 0x30002
    s_lshl_b32 s37, s37, 10
    s_and_b32 s38, s28, 0xe0
    s_add_u32 s37, s37, s38
    s_and_b32 s38, s52, 3
    s_lshl_b32 s38, s38, 3
    s_add_u32 s37, s37, s38
    s_add_u32 s37, s37, 262144
    v_lshl_add_u32 v25, v4, 8, s37
    s_waitcnt lgkmcnt(0)
    s_mul_i32 s30, s30, 0x9E3779B1
    s_add_u32 s30, s30, 0x7F4A7C15
    v_mov_b32 v13, s30
    v_mov_b32 v15, s30
    s_cmp_ge_u32 s28, 240
    s_cbranch_scc1 L_sv1
    s_barrier
    s_barrier
    ds_read_b128 v[96:99], v21 offset:0
    ds_read_b128 v[100:103], v21 offset:1024
    ds_read_b128 v[104:107], v21 offset:2048
    ds_read_b128 v[108:111], v21 offset:3072
    ds_read_b128 v[112:115], v21 offset:4096
    ds_read_b128 v[116:119], v21 offset:5120
    ds_read_b128 v[120:123], v21 offset:6144
    ds_read_b128 v[124:127], v21 offset:7168
    s_waitcnt lgkmcnt(3)
    v_pk_add_f32 v[96:97], v[96:97], v[112:113]
    v_pk_add_f32 v[98:99], v[98:99], v[114:115]
    s_waitcnt lgkmcnt(2)
    v_pk_add_f32 v[100:101], v[100:101], v[116:117]
    v_pk_add_f32 v[102:103], v[102:103], v[118:119]
    s_waitcnt lgkmcnt(1)
    v_pk_add_f32 v[104:105], v[104:105], v[120:121]
    v_pk_add_f32 v[106:107], v[106:107], v[122:123]
    s_waitcnt lgkmcnt(0)
    v_pk_add_f32 v[108:109], v[108:109], v[124:125]
    v_pk_add_f32 v[110:111], v[110:111], v[126:127]
    v_pk_add_f32 v[96:97], v[96:97], v[104:105]
    v_pk_add_f32 v[98:99], v[98:99], v[106:107]
    v_pk_add_f32 v[100:101], v[100:101], v[108:109]
    v_pk_add_f32 v[102:103], v[102:103], v[110:111]
    v_pk_add_f32 v[96:97], v[96:97], v[100:101]
    v_pk_add_f32 v[98:99], v[98:99], v[102:103]
    v_cvt_pk_bf16_f32 v12, v96, v97
    v_cvt_pk_bf16_f32 v14, v98, v99
    global_store_dwordx4 v22, v[12:15], s[54:55]
    global_store_dwordx4 v22, v[12:15], s[26:27] sc1
    s_barrier
L_sv1:
    s_sleep 36
    global_load_dwordx4 v[32:35], v16, s[56:57] offset:0 sc1
    global_load_dwordx4 v[36:39], v16, s[56:57] offset:1024 sc1
    s_barrier
    s_branch L_qp_in
L_qp:
    global_load_dwordx4 v[32:35], v16, s[56:57] offset:0 sc1
    global_load_dwordx4 v[36:39], v16, s[56:57] offset:1024 sc1
L_qp_in:
    s_waitcnt vmcnt(0)
    v_min_u32 v4, v33, v35
    v_max_u32 v5, v33, v35
    v_min3_u32 v4, v4, v37, v39
    v_max3_u32 v5, v5, v37, v39
    v_cmp_ne_u32 vcc, s30, v4
    v_cmp_ne_u32 s[44:45], s30, v5
    s_or_b64 vcc, vcc, s[44:45]
    s_cbranch_scc0 L_qp_0
    s_sleep 4
    s_sub_u32 s40, s40, 1
    s_and_b32 s37, s40, 15
    s_cselect_b64 s[56:57], s[54:55], s[26:27]
    s_cmp_gt_i32 s40, 0
    s_cbranch_scc1 L_qp
L_qp_0:
    ds_write2_b32 v17, v32, v34 offset0:0 offset1:1
    ds_write2_b32 v17, v36, v38 offset0:136 offset1:137
L_qp_done:
    s_waitcnt lgkmcnt(0)
    s_barrier
    s_cmp_ge_u32 s28, 56
    s_cbranch_scc1 L_sv2
    global_load_dwordx4 v[64:67], v26, s[26:27] offset:-3584 sc1
    global_load_dwordx4 v[68:71], v26, s[26:27] offset:3584 sc1
    global_load_dwordx4 v[72:75], v27, s[26:27] offset:-3584 sc1
    global_load_dwordx4 v[76:79], v27, s[26:27] offset:3584 sc1
    global_load_dwordx4 v[80:83], v28, s[26:27] offset:-3584 sc1
    global_load_dwordx4 v[84:87], v28, s[26:27] offset:3584 sc1
    global_load_dwordx4 v[88:91], v29, s[26:27] offset:-3584 sc1
    global_load_dwordx4 v[92:95], v29, s[26:27] offset:3584 sc1
L_sv2:
    s_barrier
    ds_read_b128 v[8:11], v24
    ds_read_b128 v[12:15], v24 offset:16
    ds_read_b128 v[128:131], v24 offset:128
    ds_read_b128 v[132:135], v24 offset:144
    s_waitcnt lgkmcnt(0)
    v_max3_f32 v6, v8, v9, v10
    v_max3_f32 v7, v11, v12, v13
    v_max3_f32 v6, v6, v14, v15
    v_max_f32 v6, v6, v7
    v_sub_f32 v8, v8, v6
    v_sub_f32 v9, v9, v6
    v_sub_f32 v10, v10, v6
    v_sub_f32 v11, v11, v6
    v_sub_f32 v12, v12, v6
    v_sub_f32 v13, v13, v6
    v_sub_f32 v14, v14, v6
    v_sub_f32 v15, v15, v6
    v_exp_f32 v8, v8
    v_exp_f32 v9, v9
    v_exp_f32 v10, v10
    v_exp_f32 v11, v11
    v_exp_f32 v12, v12
    v_exp_f32 v13, v13
    v_exp_f32 v14, v14
    v_exp_f32 v15, v15
    v_mul_f32 v7, v8, v128
    v_fmac_f32 v7, v9, v129
    v_fmac_f32 v7, v10, v130
    v_fmac_f32 v7, v11, v131
    v_fmac_f32 v7, v12, v132
    v_fmac_f32 v7, v13, v133
    v_fmac_f32 v7, v14, v134
    v_fmac_f32 v7, v15, v135
    v_log_f32 v7, v7
    v_mov_b32 v9, s30
    v_add_f32 v8, v6, v7
    s_mov_b64 exec, 15
    global_store_dwordx2 v25, v[8:9], s[54:55]
    global_store_dwordx2 v25, v[8:9], s[26:27] sc1
    s_mov_b64 exec, -1
    s_cmp_ge_u32 s28, 56
    s_cbranch_scc1 L_sv3
    s_waitcnt vmcnt(2)
    s_branch L_hchk
L_hpoll:
    global_load_dwordx4 v[64:67], v26, s[26:27] offset:-3584 sc1
    global_load_dwordx4 v[68:71], v26, s[26:27] offset:3584 sc1
    global_load_dwordx4 v[72:75], v27, s[26:27] offset:-3584 sc1
    global_load_dwordx4 v[76:79], v27, s[26:27] offset:3584 sc1
    global_load_dwordx4 v[80:83], v28, s[26:27] offset:-3584 sc1
    global_load_dwordx4 v[84:87], v28, s[26:27] offset:3584 sc1
    global_load_dwordx4 v[88:91], v29, s[26:27] offset:-3584 sc1
    global_load_dwordx4 v[92:95], v29, s[26:27] offset:3584 sc1
    s_waitcnt vmcnt(0)
L_hchk:
    v_min3_u32 v4, v65, v67, v67
    v_max3_u32 v5, v65, v67, v67
    v_min3_u32 v4, v4, v69, v71
    v_max3_u32 v5, v5, v69, v71
    v_min3_u32 v4, v4, v73, v75
    v_max3_u32 v5, v5, v73, v75
    v_min3_u32 v4, v4, v77, v79
    v_max3_u32 v5, v5, v77, v79
    v_min3_u32 v4, v4, v81, v83
    v_max3_u32 v5, v5, v81, v83
    v_min3_u32 v4, v4, v85, v87
    v_max3_u32 v5, v5, v85, v87
    v_min3_u32 v4, v4, v89, v91
    v_max3_u32 v5, v5, v89, v91
    v_min3_u32 v4, v4, v93, v95
    v_max3_u32 v5, v5, v93, v95
    v_cmp_ne_u32 vcc, s30, v4
    v_cmp_ne_u32 s[44:45], s30, v5
    s_or_b64 vcc, vcc, s[44:45]
    s_cbranch_scc0 L_hp_ok
    s_sub_u32 s40, s40, 1
    s_sleep 4
    s_cmp_gt_i32 s40, 0
    s_cbranch_scc1 L_hpoll
L_hp_ok:
    v_lshlrev_b32 v4, 16, v64
    v_and_b32 v5, 0xffff0000, v64
    v_lshlrev_b32 v6, 16, v68
    v_and_b32 v7, 0xffff0000, v68
    v_max_f32 v4, 0, v4
    v_max_f32 v5, 0, v5
    v_mul_f32 v4, v4, v6
    v_mul_f32 v5, v5, v7
    v_cvt_pk_bf16_f32 v8, v4, v5
    v_lshlrev_b32 v4, 16, v66
    v_and_b32 v5, 0xffff0000, v66
    v_lshlrev_b32 v6, 16, v70
    v_and_b32 v7, 0xffff0000, v70
    v_max_f32 v4, 0, v4
    v_max_f32 v5, 0, v5
    v_mul_f32 v4, v4, v6
    v_mul_f32 v5, v5, v7
    v_cvt_pk_bf16_f32 v9, v4, v5
    v_lshlrev_b32 v4, 16, v72
    v_and_b32 v5, 0xffff0000, v72
    v_lshlrev_b32 v6, 16, v76
    v_and_b32 v7, 0xffff0000, v76
    v_max_f32 v4, 0, v4
    v_max_f32 v5, 0, v5
    v_mul_f32 v4, v4, v6
    v_mul_f32 v5, v5, v7
    v_cvt_pk_bf16_f32 v10, v4, v5
    v_lshlrev_b32 v4, 16, v74
    v_and_b32 v5, 0xffff0000, v74
    v_lshlrev_b32 v6, 16, v78
    v_and_b32 v7, 0xffff0000, v78
    v_max_f32 v4, 0, v4
    v_max_f32 v5, 0, v5
    v_mul_f32 v4, v4, v6
    v_mul_f32 v5, v5, v7
    v_cvt_pk_bf16_f32 v11, v4, v5
    v_lshlrev_b32 v4, 16, v80
    v_and_b32 v5, 0xffff0000, v80
    v_lshlrev_b32 v6, 16, v84
    v_and_b32 v7, 0xffff0000, v84
    v_max_f32 v4, 0, v4
    v_max_f32 v5, 0, v5
    v_mul_f32 v4, v4, v6
    v_mul_f32 v5, v5, v7
    v_cvt_pk_bf16_f32 v12, v4, v5
    v_lshlrev_b32 v4, 16, v82
    v_and_b32 v5, 0xffff0000, v82
    v_lshlrev_b32 v6, 16, v86
    v_and_b32 v7, 0xffff0000, v86
    v_max_f32 v4, 0, v4
    v_max_f32 v5, 0, v5
    v_mul_f32 v4, v4, v6
    v_mul_f32 v5, v5, v7
    v_cvt_pk_bf16_f32 v13, v4, v5
    v_lshlrev_b32 v4, 16, v88
    v_and_b32 v5, 0xffff0000, v88
    v_lshlrev_b32 v6, 16, v92
    v_and_b32 v7, 0xffff0000, v92
    v_max_f32 v4, 0, v4
    v_max_f32 v5, 0, v5
    v_mul_f32 v4, v4, v6
    v_mul_f32 v5, v5, v7
    v_cvt_pk_bf16_f32 v14, v4, v5
    v_lshlrev_b32 v4, 16, v90
    v_and_b32 v5, 0xffff0000, v90
    v_lshlrev_b32 v6, 16, v94
    v_and_b32 v7, 0xffff0000, v94
    v_max_f32 v4, 0, v4
    v_max_f32 v5, 0, v5
    v_mul_f32 v4, v4, v6
    v_mul_f32 v5, v5, v7
    v_cvt_pk_bf16_f32 v15, v4, v5
    ds_write_b64 v20, v[8:9] offset:0
    ds_write_b64 v20, v[10:11] offset:544
    ds_write_b64 v20, v[12:13] offset:1088
    ds_write_b64 v20, v[14:15] offset:1632
L_sv5:
    s_waitcnt lgkmcnt(0)
    s_barrier
L_sv3:
    s_endpgm
.section .rodata,"a"
.p2align 6
.amdhsa_kernel recurrent_scan__sliding_block_cached__glu_gated_reglu__decode_kernel
  .amdhsa_next_free_vgpr 164
  .amdhsa_next_free_sgpr 96
  .amdhsa_accum_offset 164
  .amdhsa_group_segment_fixed_size 0
  .amdhsa_kernarg_size 96
  .amdhsa_user_sgpr_count 2
  .amdhsa_user_sgpr_kernarg_segment_ptr 1
  .amdhsa_system_sgpr_workgroup_id_x 1
.end_amdhsa_kernel
```
